```python
import torch

def _softmax(x, axis=-1):
    return torch.softmax(x, dim=axis)
def _gelu(x):
    return torch.nn.functional.gelu(x, approximate="tanh")
def _silu(x):
    return torch.nn.functional.silu(x)
def _sigmoid(x):
    return torch.sigmoid(x)
def _layernorm(x, axis=-1, eps=1e-5):
    m = x.mean(dim=axis, keepdim=True)
    v = x.var(dim=axis, keepdim=True, unbiased=False)
    return (x - m) / torch.sqrt(v + eps)
def _scatter_add(tgt, idx, src, axis=0):
    return tgt.clone().index_add_(axis, idx, src)
def _segment_sum(src, seg, n):
    out = torch.zeros((n,) + src.shape[1:], dtype=src.dtype)
    return out.index_add_(0, seg, src)
def _pad(x, pw):
    flat = tuple(v for pair in reversed(pw) for v in pair)
    return torch.nn.functional.pad(x, flat)

kernel_name = 'recurrent_scan__sliding_block_cached__geglu_ffn__decode'

def setup_inputs():

    _w = (lambda a: (lambda t: t.to(torch.bfloat16) if t.is_floating_point() else t)(torch.as_tensor(a)))
    def _A_setup():
        B, Sq, D = 8, 1, 512
        Hq, Hkv, Sk, Dh = 32, 8, 4096, 128
        assert Hq % Hkv == 0, (Hq, Hkv)
        return {
            "x": _w((lambda *s: torch.randn(*s, dtype=torch.bfloat16) * 0.05)(B, Sq, D)),
            "k_cache": _w((lambda *s: torch.randn(*s, dtype=torch.bfloat16) * 0.8)(B, Hkv, Sk, Dh)),
            "v_cache": _w((lambda *s: torch.randn(*s, dtype=torch.bfloat16) * 0.2)(B, Hkv, Sk, Dh)),
            "wq": _w((lambda *s: torch.randn(*s, dtype=torch.bfloat16) * 0.8)(D, Hq * Dh) * (D ** -0.5)),
            "wo": _w((lambda *s: torch.randn(*s, dtype=torch.bfloat16) * 0.2)(Hq * Dh, D) * ((Hq * Dh) ** -0.5)),
        }
    _A_in = _A_setup()

    def _B_setup():
        B, S, D, F = 8, 1, 512, 1792
        return {
            "x": _w((lambda *s: torch.randn(*s, dtype=torch.bfloat16) * 0.05)(B, S, D)),
            "w_gate": _w((lambda *s: torch.randn(*s, dtype=torch.bfloat16) * 0.1)(D, F)),
            "w_up": _w((lambda *s: torch.randn(*s, dtype=torch.bfloat16) * 0.1)(D, F)),
            "w_down": _w((lambda *s: torch.randn(*s, dtype=torch.bfloat16) * 0.1)(F, D)),
        }
    _B_in = _B_setup()

    return {
        "A_x": _A_in["x"],
        "A_k_cache": _A_in["k_cache"],
        "A_v_cache": _A_in["v_cache"],
        "A_wq": _A_in["wq"],
        "A_wo": _A_in["wo"],
        "B_x": _B_in["x"],
        "B_w_gate": _B_in["w_gate"],
        "B_w_up": _B_in["w_up"],
        "B_w_down": _B_in["w_down"],
    }

def reference(A_x, A_k_cache, A_v_cache, A_wq, A_wo, B_x, B_w_gate, B_w_up, B_w_down):
    def _A_ref(x, k_cache, v_cache, wq, wo):
        B, Sq, D = x.shape
        Hq, Dh = 32, 128
        Hkv, Sk = k_cache.shape[1], k_cache.shape[2]
        W = min(4096, max(256, Sk // 4))
        rep = Hq // Hkv
        q = (lambda x, *d: x.permute(*d))((x @ wq).reshape(B, Sq, Hq, Dh), 0, 2, 1, 3)
        k = (lambda x, n, axis: torch.repeat_interleave(x, n, dim=axis))(k_cache[:, :, Sk - W:, :], rep, axis=1)
        v = (lambda x, n, axis: torch.repeat_interleave(x, n, dim=axis))(v_cache[:, :, Sk - W:, :], rep, axis=1)
        scores = torch.einsum("bhqd,bhkd->bhqk", q, k) * (Dh ** -0.5)
        p = _softmax(scores, axis=-1)
        o = torch.einsum("bhqk,bhkd->bhqd", p, v)
        return (lambda x, *d: x.permute(*d))(o, 0, 2, 1, 3).reshape(B, Sq, Hq * Dh) @ wo

    def _B_ref(x, w_gate, w_up, w_down):
        return (_gelu(x @ w_gate) * (x @ w_up)) @ w_down

    x = A_x
    xn = _layernorm(x, axis=-1)
    s = _A_ref(xn, A_k_cache, A_v_cache, A_wq, A_wo)
    g = _silu(_B_ref(xn, B_w_gate, B_w_up, B_w_down))
    return x + s * g
```

```asm
; @launch grid=(256,1,1) block=(768,1,1) lds=163840
.amdgcn_target "amdgcn-amd-amdhsa--gfx950"
.text
.globl recurrent_scan__sliding_block_cached__geglu_ffn__decode_kernel
.p2align 8
.type recurrent_scan__sliding_block_cached__geglu_ffn__decode_kernel,@function
recurrent_scan__sliding_block_cached__geglu_ffn__decode_kernel:
  s_cmp_ge_u32 s2, 256
  s_cbranch_scc1 L_end
  s_load_dwordx16 s[4:19], s[0:1], 0
  s_load_dwordx4 s[20:23], s[0:1], 64
  s_load_dwordx4 s[24:27], s[0:1], 80
  v_lshrrev_b32 v1, 6, v0
  v_and_b32 v0, 63, v0
  v_readfirstlane_b32 s28, v1
  s_and_b32 s29, s2, 7
  s_lshr_b32 s30, s2, 3
  s_and_b32 s31, s30, 7
  s_lshr_b32 s32, s30, 3
  v_and_b32 v1, 15, v0
  v_lshrrev_b32 v2, 4, v0
  v_lshlrev_b32 v3, 4, v0
  s_cmp_eq_u32 s31, 7
  s_cselect_b32 s53, 0, s31
  s_add_u32 s53, s53, s29
  s_and_b32 s53, s53, 7
  s_lshl_b32 s54, s31, 3
  s_add_u32 s54, s54, s53
  s_cmp_lt_u32 s28, 8
  s_cbranch_scc1 L_compute
  s_and_b32 s55, s28, 3
  s_lshl_b32 s53, s55, 2
  v_add_u32 v10, s53, v2
  v_xor_b32 v10, v10, v1
  v_lshlrev_b32 v10, 4, v10
  v_lshl_add_u32 v9, v2, 8, v10
  s_lshl_b32 s56, s54, 20
  s_mul_i32 s57, s32, 49152
  s_mul_i32 s58, s32, 81920
  s_sub_u32 s58, s58, 65536
  s_cmp_lt_u32 s32, 2
  s_cselect_b32 s57, s57, s58
  s_add_u32 s56, s56, s57
  s_add_u32 s60, s56, 0xC0000
  s_lshl_b32 s52, s55, 10
  s_waitcnt lgkmcnt(0)
  s_cmp_lt_u32 s32, 2
  s_cbranch_scc1 L_ld_heavy
  s_mov_b32 s36, s6
  s_mov_b32 s37, s7
  s_mov_b32 s38, 0x4000000
  s_mov_b32 s39, 0x20000
  s_add_u32 s58, s60, s52
  s_add_u32 s62, s52, 0
  s_mov_b32 s33, 2
L_dl1:
  s_mov_b32 m0, s62
  s_add_u32 s62, s62, 4096
  buffer_load_dwordx4 v9, s[36:39], s58 offen nt lds
  s_add_u32 s58, s58, 4096
  s_sub_u32 s33, s33, 1
  s_cmp_lg_u32 s33, 0
  s_cbranch_scc1 L_dl1
  s_mul_i32 s98, s30, 12
  s_add_u32 s98, s98, s28
  s_lshl_b32 s98, s98, 6
  s_cmp_ge_u32 s98, L_code_bytes
  s_cbranch_scc1 L_pf2
  s_getpc_b64 s[96:97]
L_pf2_pc:
  s_sub_u32 s98, s98, L_pf2_pc-recurrent_scan__sliding_block_cached__geglu_ffn__decode_kernel
  s_ashr_i32 s99, s98, 31
  s_add_u32 s96, s96, s98
  s_addc_u32 s97, s97, s99
  s_load_dwordx16 s[64:79], s[96:97], 0
L_pf2:
  s_mov_b32 s44, s8
  s_mov_b32 s45, s9
  s_mov_b32 s46, 0x4000000
  s_mov_b32 s47, 0x20000
  v_lshlrev_b32 v7, 1, v2
  v_and_b32 v8, 7, v0
  v_xor_b32 v7, v7, v8
  v_lshlrev_b32 v7, 4, v7
  v_lshrrev_b32 v8, 3, v0
  s_and_b32 s53, s55, 1
  s_lshl_b32 s53, s53, 2
  v_add_u32 v11, s53, v2
  v_lshlrev_b32 v11, 1, v11
  v_xor_b32 v11, v11, v1
  v_lshlrev_b32 v11, 4, v11
  v_lshl_add_u32 v12, v2, 8, v11
  v_lshl_add_u32 v13, v2, 10, v11
  v_lshl_add_u32 v6, v8, 10, v7
  v_add_u32 v14, s52, v3
  v_mov_b32 v15, 155136
  v_mov_b32 v4, 1
  s_lshl_b32 s56, s31, 1
  s_add_u32 s56, s56, s32
  s_sub_u32 s3, s56, 2
  s_waitcnt vmcnt(0)
  s_mov_b32 s33, 18
L_dl3:
  s_mov_b32 m0, s62
  s_add_u32 s62, s62, 4096
  buffer_load_dwordx4 v9, s[36:39], s58 offen nt lds
  s_add_u32 s58, s58, 4096
  s_sub_u32 s33, s33, 1
  s_cmp_lg_u32 s33, 0
  s_cbranch_scc1 L_dl3
  s_add_u32 s58, s60, s52
  s_add_u32 s58, s58, 65536
  buffer_load_dwordx4 v[16:19], v12, s[44:47], s58 offen nt
  s_add_u32 s58, s58, 4096
  buffer_load_dwordx4 v[20:23], v12, s[44:47], s58 offen nt
  s_add_u32 s58, s58, 4096
  buffer_load_dwordx4 v[24:27], v12, s[44:47], s58 offen nt
  s_add_u32 s58, s58, 4096
  buffer_load_dwordx4 v[28:31], v12, s[44:47], s58 offen nt
  s_add_u32 s58, s60, s52
  s_add_u32 s62, s52, 81920
  s_mov_b32 s33, 8
L_dl4:
  s_mov_b32 m0, s62
  s_add_u32 s62, s62, 4096
  buffer_load_dwordx4 v12, s[44:47], s58 offen nt lds
  s_add_u32 s58, s58, 4096
  s_sub_u32 s33, s33, 1
  s_cmp_lg_u32 s33, 0
  s_cbranch_scc1 L_dl4
  s_barrier
  s_waitcnt vmcnt(24)
  s_mov_b64 exec, 1
  ds_add_u32 v15, v4 offset:28
  s_mov_b64 exec, -1
  s_waitcnt vmcnt(12)
  s_mov_b64 exec, 1
  ds_add_u32 v15, v4 offset:0
  s_mov_b64 exec, -1
  s_mov_b32 s33, 8
L_dl5:
  s_mov_b32 m0, s62
  s_add_u32 s62, s62, 4096
  buffer_load_dwordx4 v12, s[44:47], s58 offen nt lds
  s_add_u32 s58, s58, 4096
  s_sub_u32 s33, s33, 1
  s_cmp_lg_u32 s33, 0
  s_cbranch_scc1 L_dl5
  s_mov_b32 s36, s12
  s_mov_b32 s37, s13
  s_mov_b32 s38, 0x400000
  s_mov_b32 s39, 0x20000
  s_add_u32 s56, s29, 7
  s_and_b32 s56, s56, 7
  s_lshl_b32 s56, s56, 3
  s_add_u32 s56, s56, s31
  s_lshl_b32 s56, s56, 16
  s_lshl_b32 s57, s32, 8
  s_add_u32 s56, s56, s57
  s_lshl_b32 s57, s55, 12
  s_add_u32 s58, s56, s57
  buffer_load_dwordx4 v[32:35], v13, s[36:39], s58 offen nt
  s_add_u32 s58, s58, 16384
  buffer_load_dwordx4 v[36:39], v13, s[36:39], s58 offen nt
  s_add_u32 s58, s58, 16384
  buffer_load_dwordx4 v[40:43], v13, s[36:39], s58 offen nt
  s_add_u32 s58, s58, 16384
  buffer_load_dwordx4 v[44:47], v13, s[36:39], s58 offen nt
  s_cmp_lt_u32 s3, 14
  s_cbranch_scc0 L_ld_nowd
  s_mov_b32 s40, s20
  s_mov_b32 s41, s21
  s_mov_b32 s42, 0x1c0000
  s_mov_b32 s43, 0x20000
  s_lshl_b32 s56, s3, 17
  s_lshl_b32 s57, s29, 7
  s_add_u32 s56, s56, s57
  s_lshl_b32 s57, s55, 13
  s_add_u32 s58, s56, s57
  buffer_load_dwordx4 v[48:51], v6, s[40:43], s58 offen nt
  s_add_u32 s58, s58, 32768
  buffer_load_dwordx4 v[52:55], v6, s[40:43], s58 offen nt
  s_add_u32 s58, s58, 32768
  buffer_load_dwordx4 v[56:59], v6, s[40:43], s58 offen nt
  s_add_u32 s58, s58, 32768
  buffer_load_dwordx4 v[60:63], v6, s[40:43], s58 offen nt
L_spin1:
  ds_read_b32 v5, v15 offset:8
  s_waitcnt lgkmcnt(0)
  v_readfirstlane_b32 s56, v5
  s_nop 0
  s_cmp_ge_u32 s56, 8
  s_cbranch_scc0 L_spin1
  s_waitcnt vmcnt(24)
  ds_write_b128 v14, v[16:19] offset:0
  ds_write_b128 v14, v[20:23] offset:4096
  ds_write_b128 v14, v[24:27] offset:8192
  ds_write_b128 v14, v[28:31] offset:12288
  s_waitcnt lgkmcnt(0)
  s_waitcnt vmcnt(12)
  s_barrier
  s_waitcnt vmcnt(8)
  s_barrier
  s_waitcnt vmcnt(0)
  ds_write_b128 v14, v[32:35] offset:16384
  ds_write_b128 v14, v[36:39] offset:20480
  ds_write_b128 v14, v[40:43] offset:24576
  ds_write_b128 v14, v[44:47] offset:28672
  ds_write_b128 v14, v[48:51] offset:32768
  ds_write_b128 v14, v[52:55] offset:36864
  ds_write_b128 v14, v[56:59] offset:40960
  ds_write_b128 v14, v[60:63] offset:45056
  s_waitcnt lgkmcnt(0)
  s_barrier
  s_branch L_stout
L_ld_nowd:
L_spin2:
  ds_read_b32 v5, v15 offset:8
  s_waitcnt lgkmcnt(0)
  v_readfirstlane_b32 s56, v5
  s_nop 0
  s_cmp_ge_u32 s56, 8
  s_cbranch_scc0 L_spin2
  s_waitcnt vmcnt(20)
  ds_write_b128 v14, v[16:19] offset:0
  ds_write_b128 v14, v[20:23] offset:4096
  ds_write_b128 v14, v[24:27] offset:8192
  ds_write_b128 v14, v[28:31] offset:12288
  s_waitcnt lgkmcnt(0)
  s_waitcnt vmcnt(8)
  s_barrier
  s_waitcnt vmcnt(4)
  s_barrier
  s_waitcnt vmcnt(0)
  ds_write_b128 v14, v[32:35] offset:16384
  ds_write_b128 v14, v[36:39] offset:20480
  ds_write_b128 v14, v[40:43] offset:24576
  ds_write_b128 v14, v[44:47] offset:28672
  s_waitcnt lgkmcnt(0)
  s_barrier
  s_branch L_stout
L_ld_heavy:
  v_lshlrev_b32 v7, 1, v2
  v_and_b32 v8, 7, v0
  v_xor_b32 v7, v7, v8
  v_lshlrev_b32 v7, 4, v7
  v_lshrrev_b32 v8, 3, v0
  s_lshl_b32 s56, s31, 3
  s_add_u32 s56, s56, s29
  s_mov_b32 s63, s31
  s_cmp_eq_u32 s32, 0
  s_cbranch_scc1 L_roleq
  s_mov_b32 s63, 3
  s_cmp_eq_u32 s30, 15
  s_cbranch_scc1 L_roleq
  s_cmp_ge_u32 s56, 28
  s_cselect_b32 s36, s18, s16
  s_cselect_b32 s37, s19, s17
  s_cselect_b32 s57, 28, 0
  s_sub_u32 s57, s56, s57
  s_lshl_b32 s58, s57, 7
  s_mov_b32 s38, 1835008
  s_mov_b32 s59, 3584
  s_cmp_ge_u32 s57, 28
  s_cselect_b32 s38, 0, s38
  s_branch L_roled
L_roleq:
  s_mov_b32 s36, s10
  s_mov_b32 s37, s11
  s_mov_b32 s38, 0x400000
  s_add_u32 s58, s29, 7
  s_and_b32 s58, s58, 7
  s_lshl_b32 s58, s58, 10
  s_lshl_b32 s57, s63, 7
  s_add_u32 s58, s58, s57
  s_mov_b32 s59, 8192
L_roled:
  s_mov_b32 s39, 0x20000
  v_mul_lo_u32 v5, v8, s59
  v_add_u32 v5, v5, v7
  s_lshl_b32 s61, s59, 3
  s_mul_i32 s62, s61, s55
  s_add_u32 s58, s58, s62
  s_lshl_b32 s61, s61, 2
  s_add_u32 s62, s52, 81920
  s_mov_b32 s33, 16
  s_cmp_eq_u32 s30, 3
  s_cselect_b32 s33, 8, s33
  s_cmp_eq_u32 s30, 15
  s_cbranch_scc0 L_wl
  s_mov_b32 s33, 8
  s_lshl_b32 s57, s61, 3
  s_add_u32 s58, s58, s57
  s_add_u32 s62, s62, 32768
L_wl:
  s_mov_b32 m0, s62
  s_add_u32 s62, s62, 4096
  buffer_load_dwordx4 v5, s[36:39], s58 offen nt lds
  s_add_u32 s58, s58, s61
  s_sub_u32 s33, s33, 1
  s_cmp_lg_u32 s33, 0
  s_cbranch_scc1 L_wl
  s_mul_i32 s98, s30, 12
  s_add_u32 s98, s98, s28
  s_lshl_b32 s98, s98, 6
  s_cmp_ge_u32 s98, L_code_bytes
  s_cbranch_scc1 L_pf6
  s_getpc_b64 s[96:97]
L_pf6_pc:
  s_sub_u32 s98, s98, L_pf6_pc-recurrent_scan__sliding_block_cached__geglu_ffn__decode_kernel
  s_ashr_i32 s99, s98, 31
  s_add_u32 s96, s96, s98
  s_addc_u32 s97, s97, s99
  s_load_dwordx16 s[64:79], s[96:97], 0
L_pf6:
  s_mov_b32 s36, s6
  s_mov_b32 s37, s7
  s_mov_b32 s38, 0x4000000
  s_mov_b32 s39, 0x20000
  s_mov_b32 s44, s8
  s_mov_b32 s45, s9
  s_mov_b32 s46, 0x4000000
  s_mov_b32 s47, 0x20000
  s_add_u32 s58, s60, s52
  s_add_u32 s62, s52, 0
  s_and_b32 s53, s55, 1
  s_lshl_b32 s53, s53, 2
  v_add_u32 v11, s53, v2
  v_lshlrev_b32 v11, 1, v11
  v_xor_b32 v11, v11, v1
  v_lshlrev_b32 v11, 4, v11
  v_lshl_add_u32 v12, v2, 8, v11
  v_lshl_add_u32 v13, v2, 10, v11
  v_lshl_add_u32 v6, v8, 10, v7
  v_add_u32 v14, s52, v3
  v_mov_b32 v15, 155136
  v_mov_b32 v4, 1
  s_cmp_eq_u32 s30, 15
  s_cbranch_scc1 L_ld_q
  s_cmp_eq_u32 s32, 0
  s_cbranch_scc1 L_ld_q
  s_mov_b32 s33, 12
L_dl7:
  s_mov_b32 m0, s62
  s_add_u32 s62, s62, 4096
  buffer_load_dwordx4 v9, s[36:39], s58 offen nt lds
  s_add_u32 s58, s58, 4096
  s_sub_u32 s33, s33, 1
  s_cmp_lg_u32 s33, 0
  s_cbranch_scc1 L_dl7
  s_waitcnt vmcnt(12)
  s_barrier
L_spin3:
  ds_read_b32 v5, v15 offset:20
  s_waitcnt lgkmcnt(0)
  v_readfirstlane_b32 s56, v5
  s_nop 0
  s_cmp_ge_u32 s56, 8
  s_cbranch_scc0 L_spin3
  s_branch L_ld_v
L_ld_q:
  s_mov_b32 s33, 6
L_dl8:
  s_mov_b32 m0, s62
  s_add_u32 s62, s62, 4096
  buffer_load_dwordx4 v9, s[36:39], s58 offen nt lds
  s_add_u32 s58, s58, 4096
  s_sub_u32 s33, s33, 1
  s_cmp_lg_u32 s33, 0
  s_cbranch_scc1 L_dl8
  s_waitcnt vmcnt(6)
  s_barrier
L_spin4:
  ds_read_b32 v5, v15 offset:24
  s_waitcnt lgkmcnt(0)
  v_readfirstlane_b32 s56, v5
  s_nop 0
  s_cmp_ge_u32 s56, 4
  s_cbranch_scc0 L_spin4
  s_mov_b32 s33, 6
L_dl9:
  s_mov_b32 m0, s62
  s_add_u32 s62, s62, 4096
  buffer_load_dwordx4 v9, s[36:39], s58 offen nt lds
  s_add_u32 s58, s58, 4096
  s_sub_u32 s33, s33, 1
  s_cmp_lg_u32 s33, 0
  s_cbranch_scc1 L_dl9
L_spin5:
  ds_read_b32 v5, v15 offset:20
  s_waitcnt lgkmcnt(0)
  v_readfirstlane_b32 s56, v5
  s_nop 0
  s_cmp_ge_u32 s56, 8
  s_cbranch_scc0 L_spin5
L_ld_v:
  s_add_u32 s58, s60, s52
  s_add_u32 s62, s52, 81920
  s_mov_b32 s33, 8
L_dl10:
  s_mov_b32 m0, s62
  s_add_u32 s62, s62, 4096
  buffer_load_dwordx4 v12, s[44:47], s58 offen nt lds
  s_add_u32 s58, s58, 4096
  s_sub_u32 s33, s33, 1
  s_cmp_lg_u32 s33, 0
  s_cbranch_scc1 L_dl10
  s_waitcnt vmcnt(8)
  s_mov_b64 exec, 1
  ds_add_u32 v15, v4 offset:0
  s_mov_b64 exec, -1
  s_mov_b32 s33, 4
L_dl11:
  s_mov_b32 m0, s62
  s_add_u32 s62, s62, 4096
  buffer_load_dwordx4 v12, s[44:47], s58 offen nt lds
  s_add_u32 s58, s58, 4096
  s_sub_u32 s33, s33, 1
  s_cmp_lg_u32 s33, 0
  s_cbranch_scc1 L_dl11
  s_mov_b32 s36, s12
  s_mov_b32 s37, s13
  s_mov_b32 s38, 0x400000
  s_mov_b32 s39, 0x20000
  s_add_u32 s56, s29, 7
  s_and_b32 s56, s56, 7
  s_lshl_b32 s56, s56, 3
  s_add_u32 s56, s56, s31
  s_lshl_b32 s56, s56, 16
  s_lshl_b32 s57, s32, 8
  s_add_u32 s56, s56, s57
  s_lshl_b32 s57, s55, 12
  s_add_u32 s58, s56, s57
  buffer_load_dwordx4 v[32:35], v13, s[36:39], s58 offen nt
  s_add_u32 s58, s58, 16384
  buffer_load_dwordx4 v[36:39], v13, s[36:39], s58 offen nt
  s_add_u32 s58, s58, 16384
  buffer_load_dwordx4 v[40:43], v13, s[36:39], s58 offen nt
  s_add_u32 s58, s58, 16384
  buffer_load_dwordx4 v[44:47], v13, s[36:39], s58 offen nt
  s_waitcnt vmcnt(8)
  s_barrier
  s_waitcnt vmcnt(4)
  s_barrier
  s_waitcnt vmcnt(0)
  ds_write_b128 v14, v[32:35] offset:16384
  ds_write_b128 v14, v[36:39] offset:20480
  ds_write_b128 v14, v[40:43] offset:24576
  ds_write_b128 v14, v[44:47] offset:28672
  s_waitcnt lgkmcnt(0)
  s_barrier
  s_branch L_stout
  s_branch L_stout
L_compute:
  s_lshl_b32 s56, s31, 1
  s_add_u32 s56, s56, s32
  s_sub_u32 s56, s56, 2
  s_cmp_ge_u32 s32, 2
  s_cselect_b32 s56, s56, 255
  s_cmp_lt_u32 s56, 14
  s_cselect_b32 s3, s56, 255
  v_mov_b32 v9, 155136
  v_mov_b32 v8, 1
  v_mov_b32 v10, 0
  v_mov_b32 v11, 0
  s_cmp_lg_u32 s28, 0
  s_cbranch_scc1 L_nocz
  s_mov_b64 exec, 1
  ds_write_b64 v9, v[10:11]
  ds_write_b64 v9, v[10:11] offset:8
  ds_write_b64 v9, v[10:11] offset:16
  ds_write_b64 v9, v[10:11] offset:24
  ds_write_b64 v9, v[10:11] offset:32
  s_mov_b64 exec, -1
L_nocz:
  s_lshl_b32 s52, s28, 10
  v_add_u32 v12, s52, v3
  s_waitcnt lgkmcnt(0)
  s_mul_i32 s98, s30, 12
  s_add_u32 s98, s98, s28
  s_lshl_b32 s98, s98, 6
  s_cmp_ge_u32 s98, L_code_bytes
  s_cbranch_scc1 L_pf12
  s_getpc_b64 s[96:97]
L_pf12_pc:
  s_sub_u32 s98, s98, L_pf12_pc-recurrent_scan__sliding_block_cached__geglu_ffn__decode_kernel
  s_ashr_i32 s99, s98, 31
  s_add_u32 s96, s96, s98
  s_addc_u32 s97, s97, s99
  s_load_dwordx16 s[64:79], s[96:97], 0
L_pf12:
  s_load_dwordx2 s[34:35], s[26:27], 0
  s_add_u32 s15, s29, 7
  s_and_b32 s15, s15, 7
  s_mov_b32 s14, s53
  s_cmp_ge_u32 s32, 2
  s_cbranch_scc1 L_light1
  global_load_dwordx4 v[20:23], v12, s[4:5]
  s_mov_b32 s40, s26
  s_mov_b32 s41, s27
  s_mov_b32 s42, 0x200000
  s_mov_b32 s43, 0x20000
  v_bfe_u32 v64, v0, 2, 2
  v_lshl_add_u32 v65, v2, 2, v64
  v_bfe_u32 v66, v65, 1, 2
  v_lshlrev_b32 v66, 1, v66
  v_bfe_u32 v67, v0, 1, 1
  s_and_b32 s57, s28, 3
  s_lshl_b32 s57, s57, 1
  v_add_u32 v67, s57, v67
  v_xor_b32 v66, v66, v67
  v_lshlrev_b32 v66, 4, v66
  v_lshl_add_u32 v66, v65, 7, v66
  v_and_b32 v67, 1, v0
  v_lshl_add_u32 v66, v67, 3, v66
  s_lshr_b32 s57, s28, 2
  s_lshl_b32 s58, s57, 15
  s_add_u32 s58, s58, 81920
  v_add_u32 v60, s58, v66
  v_and_b32 v61, 7, v0
  v_mul_u32_u24 v61, 1056, v61
  v_lshl_add_u32 v61, v2, 4, v61
  s_lshl_b32 s58, s57, 9
  s_add_u32 s58, s58, 49152
  v_add_u32 v61, s58, v61
  s_mul_i32 s56, s28, 1056
  s_add_u32 s56, s56, 49152
  v_lshrrev_b32 v62, 2, v0
  v_lshlrev_b32 v62, 6, v62
  v_and_b32 v63, 1, v0
  v_lshl_add_u32 v62, v63, 5, v62
  v_bfe_u32 v63, v0, 1, 1
  v_lshl_add_u32 v62, v63, 3, v62
  v_add_u32 v62, s56, v62
  s_and_b32 s57, s28, 3
  s_lshl_b32 s57, s57, 10
  s_add_u32 s57, s57, 57600
  v_add_u32 v63, s57, v3
  s_waitcnt vmcnt(0)
  v_lshlrev_b32 v28, 16, v20
  v_and_b32 v29, 0xffff0000, v20
  v_lshlrev_b32 v30, 16, v21
  v_and_b32 v31, 0xffff0000, v21
  v_lshlrev_b32 v32, 16, v22
  v_and_b32 v33, 0xffff0000, v22
  v_lshlrev_b32 v34, 16, v23
  v_and_b32 v35, 0xffff0000, v23
  v_pk_add_f32 v[36:37], v[28:29], v[30:31]
  v_pk_add_f32 v[38:39], v[32:33], v[34:35]
  v_pk_add_f32 v[36:37], v[36:37], v[38:39]
  v_add_f32 v36, v36, v37
  s_nop 1
  v_add_f32_dpp v36, v36, v36 row_ror:1 row_mask:0xf bank_mask:0xf
  s_nop 1
  v_add_f32_dpp v36, v36, v36 row_ror:2 row_mask:0xf bank_mask:0xf
  s_nop 1
  v_add_f32_dpp v36, v36, v36 row_ror:4 row_mask:0xf bank_mask:0xf
  s_nop 1
  v_add_f32_dpp v36, v36, v36 row_ror:8 row_mask:0xf bank_mask:0xf
  v_mov_b32 v37, v36
  s_nop 1
  v_permlane16_swap_b32 v36, v37
  v_add_f32 v36, v36, v37
  v_mov_b32 v37, v36
  s_nop 1
  v_permlane32_swap_b32 v36, v37
  v_add_f32 v36, v36, v37
  v_mul_f32 v36, 0x3b000000, v36
  v_sub_f32 v40, v28, v36
  v_sub_f32 v41, v29, v36
  v_sub_f32 v42, v30, v36
  v_sub_f32 v43, v31, v36
  v_sub_f32 v44, v32, v36
  v_sub_f32 v45, v33, v36
  v_sub_f32 v46, v34, v36
  v_sub_f32 v47, v35, v36
  v_mul_f32 v37, v40, v40
  v_fmac_f32 v37, v41, v41
  v_fmac_f32 v37, v42, v42
  v_fmac_f32 v37, v43, v43
  v_fmac_f32 v37, v44, v44
  v_fmac_f32 v37, v45, v45
  v_fmac_f32 v37, v46, v46
  v_fmac_f32 v37, v47, v47
  s_nop 1
  v_add_f32_dpp v37, v37, v37 row_ror:1 row_mask:0xf bank_mask:0xf
  s_nop 1
  v_add_f32_dpp v37, v37, v37 row_ror:2 row_mask:0xf bank_mask:0xf
  s_nop 1
  v_add_f32_dpp v37, v37, v37 row_ror:4 row_mask:0xf bank_mask:0xf
  s_nop 1
  v_add_f32_dpp v37, v37, v37 row_ror:8 row_mask:0xf bank_mask:0xf
  v_mov_b32 v38, v37
  s_nop 1
  v_permlane16_swap_b32 v37, v38
  v_add_f32 v37, v37, v38
  v_mov_b32 v38, v37
  s_nop 1
  v_permlane32_swap_b32 v37, v38
  v_add_f32 v37, v37, v38
  v_mul_f32 v37, 0x3b000000, v37
  v_cvt_pk_bf16_f32 v36, v36, v36
  v_lshlrev_b32 v36, 16, v36
  v_cvt_pk_bf16_f32 v37, v37, v37
  v_lshlrev_b32 v37, 16, v37
  v_add_f32 v37, 0x3727c5ac, v37
  v_cvt_pk_bf16_f32 v37, v37, v37
  v_lshlrev_b32 v37, 16, v37
  v_sqrt_f32 v37, v37
  s_nop 0
  v_cvt_pk_bf16_f32 v37, v37, v37
  v_lshlrev_b32 v37, 16, v37
  v_rcp_f32 v38, v37
  v_sub_f32 v40, v28, v36
  v_sub_f32 v41, v29, v36
  v_sub_f32 v42, v30, v36
  v_sub_f32 v43, v31, v36
  v_sub_f32 v44, v32, v36
  v_sub_f32 v45, v33, v36
  v_sub_f32 v46, v34, v36
  v_sub_f32 v47, v35, v36
  v_cvt_pk_bf16_f32 v48, v40, v41
  v_cvt_pk_bf16_f32 v49, v42, v43
  v_cvt_pk_bf16_f32 v50, v44, v45
  v_cvt_pk_bf16_f32 v51, v46, v47
  v_lshlrev_b32 v40, 16, v48
  v_and_b32 v41, 0xffff0000, v48
  v_lshlrev_b32 v42, 16, v49
  v_and_b32 v43, 0xffff0000, v49
  v_lshlrev_b32 v44, 16, v50
  v_and_b32 v45, 0xffff0000, v50
  v_lshlrev_b32 v46, 16, v51
  v_and_b32 v47, 0xffff0000, v51
  v_mul_f32 v28, v40, v38
  v_mul_f32 v29, v41, v38
  v_mul_f32 v30, v42, v38
  v_mul_f32 v31, v43, v38
  v_mul_f32 v32, v44, v38
  v_mul_f32 v33, v45, v38
  v_mul_f32 v34, v46, v38
  v_mul_f32 v35, v47, v38
  v_fma_f32 v52, -v28, v37, v40
  v_fma_f32 v53, -v29, v37, v41
  v_fma_f32 v54, -v30, v37, v42
  v_fma_f32 v55, -v31, v37, v43
  v_fma_f32 v56, -v32, v37, v44
  v_fma_f32 v57, -v33, v37, v45
  v_fma_f32 v58, -v34, v37, v46
  v_fma_f32 v59, -v35, v37, v47
  v_fmac_f32 v28, v52, v38
  v_fmac_f32 v29, v53, v38
  v_fmac_f32 v30, v54, v38
  v_fmac_f32 v31, v55, v38
  v_fmac_f32 v32, v56, v38
  v_fmac_f32 v33, v57, v38
  v_fmac_f32 v34, v58, v38
  v_fmac_f32 v35, v59, v38
  v_cvt_pk_bf16_f32 v48, v28, v29
  v_cvt_pk_bf16_f32 v49, v30, v31
  v_cvt_pk_bf16_f32 v50, v32, v33
  v_cvt_pk_bf16_f32 v51, v34, v35
  ds_write_b64 v62, v[48:49]
  ds_write_b64 v62, v[50:51] offset:16
  s_waitcnt lgkmcnt(0)
  s_add_u32 s34, s34, 0x7f4a7c15
  s_addc_u32 s35, s35, 0x9e3779b9
  s_barrier
  s_mov_b32 s53, 3
  s_cmp_eq_u32 s30, 3
  s_cselect_b32 s53, 1, s53
  s_cmp_eq_u32 s30, 15
  s_cselect_b32 s53, 2, s53
  s_lshr_b32 s57, s28, 2
  s_add_u32 s57, s57, 1
  s_and_b32 s57, s57, s53
  s_cmp_lg_u32 s57, 0
  s_cbranch_scc1 L_gemv_go
  v_mov_b32 v56, 0
  v_mov_b32 v57, 0
  v_mov_b32 v58, 0
  v_mov_b32 v59, 0
  s_branch L_gemv_end
L_gemv_go:
  ds_read_b128 v[64:67], v61 offset:0
  ds_read_b64_tr_b16 v[68:69], v60 offset:0
  ds_read_b64_tr_b16 v[70:71], v60 offset:2048
  ds_read_b128 v[72:75], v61 offset:64
  ds_read_b64_tr_b16 v[76:77], v60 offset:4096
  ds_read_b64_tr_b16 v[78:79], v60 offset:6144
  ds_read_b128 v[80:83], v61 offset:128
  ds_read_b64_tr_b16 v[84:85], v60 offset:8192
  ds_read_b64_tr_b16 v[86:87], v60 offset:10240
  s_waitcnt lgkmcnt(6)
  v_mfma_f32_16x16x32_bf16 v[56:59], v[68:71], v[64:67], 0
  ds_read_b128 v[88:91], v61 offset:192
  ds_read_b64_tr_b16 v[92:93], v60 offset:12288
  ds_read_b64_tr_b16 v[94:95], v60 offset:14336
  s_waitcnt lgkmcnt(6)
  v_mfma_f32_16x16x32_bf16 v[56:59], v[76:79], v[72:75], v[56:59]
  ds_read_b128 v[64:67], v61 offset:256
  ds_read_b64_tr_b16 v[68:69], v60 offset:16384
  ds_read_b64_tr_b16 v[70:71], v60 offset:18432
  s_waitcnt lgkmcnt(6)
  v_mfma_f32_16x16x32_bf16 v[56:59], v[84:87], v[80:83], v[56:59]
  ds_read_b128 v[72:75], v61 offset:320
  ds_read_b64_tr_b16 v[76:77], v60 offset:20480
  ds_read_b64_tr_b16 v[78:79], v60 offset:22528
  s_waitcnt lgkmcnt(6)
  v_mfma_f32_16x16x32_bf16 v[56:59], v[92:95], v[88:91], v[56:59]
  ds_read_b128 v[80:83], v61 offset:384
  ds_read_b64_tr_b16 v[84:85], v60 offset:24576
  ds_read_b64_tr_b16 v[86:87], v60 offset:26624
  s_waitcnt lgkmcnt(6)
  v_mfma_f32_16x16x32_bf16 v[56:59], v[68:71], v[64:67], v[56:59]
  ds_read_b128 v[88:91], v61 offset:448
  ds_read_b64_tr_b16 v[92:93], v60 offset:28672
  ds_read_b64_tr_b16 v[94:95], v60 offset:30720
  s_waitcnt lgkmcnt(6)
  v_mfma_f32_16x16x32_bf16 v[56:59], v[76:79], v[72:75], v[56:59]
  s_waitcnt lgkmcnt(3)
  v_mfma_f32_16x16x32_bf16 v[56:59], v[84:87], v[80:83], v[56:59]
  s_waitcnt lgkmcnt(0)
  v_mfma_f32_16x16x32_bf16 v[56:59], v[92:95], v[88:91], v[56:59]
L_gemv_end:
  s_mov_b64 exec, 1
  ds_add_u32 v9, v8 offset:20
  s_mov_b64 exec, -1
  s_cmp_lt_u32 s28, 4
  s_cbranch_scc1 L_gemv_lo
  s_nop 4
  ds_write_b128 v63, v[56:59]
  s_mov_b64 exec, 1
  ds_add_u32 v9, v8 offset:16
  s_mov_b64 exec, -1
  s_branch L_B2h
L_gemv_lo:
  s_lshl_b32 s55, s31, 3
  s_add_u32 s55, s55, s29
  s_cmp_eq_u32 s32, 0
  s_cbranch_scc1 L_adq
  s_cmp_eq_u32 s30, 15
  s_cbranch_scc1 L_adh
  s_cmp_ge_u32 s55, 28
  s_cselect_b32 s57, 28, 0
  s_mov_b32 s58, 16384
  s_cselect_b32 s58, 73728, s58
  s_sub_u32 s57, s55, s57
  s_lshl_b32 s57, s57, 11
  s_add_u32 s59, s57, s58
  v_lshlrev_b32 v52, 8, v1
  s_branch L_add
L_adh:
  s_lshl_b32 s59, s15, 8
  s_add_u32 s59, s59, 278528
  v_lshlrev_b32 v52, 11, v1
  s_branch L_add
L_adq:
  s_lshl_b32 s59, s15, 11
  s_lshl_b32 s57, s31, 8
  s_add_u32 s59, s59, s57
  s_add_u32 s59, s59, 131072
  v_lshlrev_b32 v52, 14, v1
L_add:
  s_lshl_b32 s57, s28, 6
  s_add_u32 s59, s59, s57
  v_lshl_add_u32 v52, v2, 4, v52
  v_mov_b32 v46, s34
  v_mov_b32 v47, s35
L_spin6:
  ds_read_b32 v40, v9 offset:16
  s_waitcnt lgkmcnt(0)
  v_readfirstlane_b32 s56, v40
  s_nop 0
  s_cmp_ge_u32 s56, 4
  s_cbranch_scc0 L_spin6
  ds_read_b128 v[60:63], v63
  s_waitcnt lgkmcnt(0)
  v_pk_add_f32 v[56:57], v[56:57], v[60:61]
  v_pk_add_f32 v[58:59], v[58:59], v[62:63]
  s_cmp_eq_u32 s32, 0
  s_cbranch_scc1 L_pubgo
  s_cmp_eq_u32 s30, 15
  s_cbranch_scc1 L_pubgo
  s_cmp_ge_u32 s55, 56
  s_cbranch_scc1 L_B2h
  s_cmp_ge_u32 s55, 28
  s_cbranch_scc1 L_pubgo
  v_cvt_pk_bf16_f32 v56, v56, v56
  v_lshlrev_b32 v56, 16, v56
  v_cvt_pk_bf16_f32 v57, v57, v57
  v_lshlrev_b32 v57, 16, v57
  v_cvt_pk_bf16_f32 v58, v58, v58
  v_lshlrev_b32 v58, 16, v58
  v_cvt_pk_bf16_f32 v59, v59, v59
  v_lshlrev_b32 v59, 16, v59
  v_mul_f32 v64, v56, v56
  v_mul_f32 v64, v64, v56
  v_mul_f32 v64, 0x3d372713, v64
  v_add_f32 v64, v56, v64
  v_mul_f32 v64, 0xc0135761, v64
  v_mul_f32 v65, v57, v57
  v_mul_f32 v65, v65, v57
  v_mul_f32 v65, 0x3d372713, v65
  v_add_f32 v65, v57, v65
  v_mul_f32 v65, 0xc0135761, v65
  v_mul_f32 v66, v58, v58
  v_mul_f32 v66, v66, v58
  v_mul_f32 v66, 0x3d372713, v66
  v_add_f32 v66, v58, v66
  v_mul_f32 v66, 0xc0135761, v66
  v_mul_f32 v67, v59, v59
  v_mul_f32 v67, v67, v59
  v_mul_f32 v67, 0x3d372713, v67
  v_add_f32 v67, v59, v67
  v_mul_f32 v67, 0xc0135761, v67
  v_exp_f32 v64, v64
  v_exp_f32 v65, v65
  v_exp_f32 v66, v66
  v_exp_f32 v67, v67
  v_add_f32 v64, 1.0, v64
  v_add_f32 v65, 1.0, v65
  v_add_f32 v66, 1.0, v66
  v_add_f32 v67, 1.0, v67
  v_rcp_f32 v64, v64
  v_rcp_f32 v65, v65
  v_rcp_f32 v66, v66
  v_rcp_f32 v67, v67
  v_mul_f32 v56, v56, v64
  v_mul_f32 v57, v57, v65
  v_mul_f32 v58, v58, v66
  v_mul_f32 v59, v59, v67
L_pubgo:
  v_cvt_pk_bf16_f32 v44, v56, v57
  v_cvt_pk_bf16_f32 v45, v58, v59
  s_mov_b32 exec_lo, 0x00ff00ff
  s_mov_b32 exec_hi, 0x00ff00ff
  buffer_store_dwordx4 v[44:47], v52, s[40:43], s59 offen sc1
  s_mov_b64 exec, -1
  s_mov_b64 exec, 1
  ds_add_u32 v9, v8 offset:24
  s_mov_b64 exec, -1
L_B2h:
  s_branch L_common
L_light1:
  s_waitcnt lgkmcnt(0)
  s_add_u32 s34, s34, 0x7f4a7c15
  s_addc_u32 s35, s35, 0x9e3779b9
L_common:
  s_and_b32 s16, s34, 0xfff
  s_bfe_u32 s17, s34, 0xc000c
  s_lshr_b32 s18, s34, 24
  s_lshl_b32 s56, s35, 8
  s_or_b32 s18, s18, s56
  s_and_b32 s18, s18, 0xfff
  s_bfe_u32 s19, s35, 0xc0004
  v_mov_b32 v15, 0xfffff000
  s_cmp_ge_u32 s32, 2
  s_cselect_b32 s13, 10, 6
  s_lshl_b32 s57, s31, 3
  s_add_u32 s57, s57, s14
  s_lshl_b32 s57, s57, 2
  s_add_u32 s57, s57, s32
  s_lshl_b32 s58, s57, 6
  s_add_u32 s9, s58, 262144
  s_lshl_b32 s58, s57, 11
  s_lshl_b32 s59, s28, 8
  s_add_u32 s58, s58, s59
  s_add_u32 s6, s58, 524288
  v_lshlrev_b32 v16, 6, v1
  v_lshl_add_u32 v16, v2, 4, v16
  s_lshl_b32 s57, s28, 3
  s_add_u32 s57, s57, s15
  s_lshl_b32 s57, s57, 2
  s_lshr_b32 s59, s31, 1
  s_and_b32 s60, s31, 1
  s_lshl_b32 s58, s57, 6
  s_lshl_b32 s61, s59, 4
  s_add_u32 s58, s58, s61
  s_add_u32 s8, s58, 262144
  s_lshl_b32 s58, s57, 11
  s_lshl_b32 s61, s59, 6
  s_add_u32 s58, s58, s61
  s_lshl_b32 s61, s60, 10
  s_add_u32 s58, s58, s61
  s_add_u32 s7, s58, 524288
  v_and_b32 v40, 3, v0
  v_lshrrev_b32 v41, 2, v0
  v_lshlrev_b32 v24, 6, v40
  v_lshlrev_b32 v19, 11, v40
  v_lshrrev_b32 v42, 2, v41
  v_lshl_add_u32 v19, v42, 8, v19
  v_and_b32 v42, 3, v41
  v_lshl_add_u32 v19, v42, 4, v19
  s_mul_i32 s58, s28, 160
  s_add_u32 s58, s58, 151552
  v_lshrrev_b32 v42, 3, v41
  v_lshlrev_b32 v42, 6, v42
  v_and_b32 v43, 3, v41
  v_lshl_add_u32 v42, v43, 4, v42
  v_bfe_u32 v43, v41, 2, 1
  v_lshl_add_u32 v42, v43, 3, v42
  v_add_u32 v25, s58, v42
  v_and_b32 v26, 7, v0
  v_mul_u32_u24 v27, 160, v26
  v_lshl_add_u32 v27, v2, 4, v27
  v_add_u32 v27, 151552, v27
  s_lshl_b32 s57, s15, 3
  s_add_u32 s57, s57, s31
  s_lshl_b32 s58, s57, 14
  s_lshl_b32 s59, s32, 9
  s_add_u32 s58, s58, s59
  s_lshl_b32 s59, s28, 6
  s_add_u32 s58, s58, s59
  s_add_u32 s10, s58, 1048576
  s_lshl_b32 s58, s3, 14
  s_lshl_b32 s60, s29, 8
  s_add_u32 s58, s58, s60
  s_add_u32 s58, s58, s59
  s_add_u32 s11, s58, 294912
  v_lshlrev_b32 v28, 11, v1
  v_lshl_add_u32 v28, v2, 4, v28
  v_mov_b32 v38, v28
  v_bfe_u32 v40, v0, 2, 2
  v_lshl_add_u32 v41, v2, 2, v40
  v_and_b32 v42, 7, v41
  v_lshlrev_b32 v42, 1, v42
  v_bfe_u32 v43, v0, 1, 1
  s_lshl_b32 s58, s28, 1
  v_add_u32 v43, s58, v43
  v_xor_b32 v42, v42, v43
  v_lshlrev_b32 v42, 4, v42
  v_lshl_add_u32 v42, v41, 8, v42
  v_and_b32 v43, 1, v0
  v_lshl_add_u32 v18, v43, 3, v42
  v_add_u32 v17, 81920, v18
  v_and_b32 v40, 3, v0
  v_mul_u32_u24 v29, 288, v40
  v_lshl_add_u32 v29, v2, 4, v29
  v_add_u32 v29, 147456, v29
  v_xor_b32 v30, v2, v1
  v_lshlrev_b32 v30, 4, v30
  v_lshl_add_u32 v30, v1, 8, v30
  v_lshlrev_b32 v41, 5, v40
  s_lshl_b32 s58, s28, 2
  s_add_u32 s58, s58, 151296
  v_add_u32 v31, s58, v41
  v_add_u32 v32, 151296, v41
  v_add_u32 v35, 151424, v41
  s_lshl_b32 s58, s28, 8
  s_add_u32 s58, s58, 148736
  v_lshlrev_b32 v33, 6, v1
  v_lshl_add_u32 v33, v2, 4, v33
  v_add_u32 v33, s58, v33
  v_lshlrev_b32 v34, 6, v40
  v_lshl_add_u32 v34, v2, 4, v34
  v_add_u32 v34, 148736, v34
  s_lshl_b32 s58, s3, 12
  s_lshl_b32 s59, s28, 8
  s_add_u32 s12, s58, s59
  v_and_b32 v40, 1, v2
  v_lshlrev_b32 v40, 11, v40
  v_lshl_add_u32 v40, v1, 4, v40
  v_mov_b32 v41, 16384
  v_mov_b32 v42, 73728
  v_cmp_le_u32 vcc, 32, v0
  s_nop 1
  v_cndmask_b32 v41, v41, v42, vcc
  v_add_u32 v36, v40, v41
  s_mul_i32 s58, s28, 288
  s_add_u32 s58, s58, 152832
  v_bfe_u32 v40, v0, 3, 2
  v_lshlrev_b32 v40, 6, v40
  v_and_b32 v41, 3, v0
  v_lshl_add_u32 v40, v41, 4, v40
  v_bfe_u32 v41, v0, 2, 1
  v_lshl_add_u32 v40, v41, 3, v40
  v_add_u32 v37, s58, v40
  s_lshl_b32 s56, s31, 14
  s_lshl_b32 s57, s14, 11
  s_add_u32 s56, s56, s57
  s_lshl_b32 s57, s28, 8
  s_add_u32 s56, s56, s57
  s_add_u32 s56, s56, 131072
  s_add_u32 s0, s26, s56
  s_addc_u32 s1, s27, 0
  s_lshr_b32 s56, s28, 1
  s_mul_i32 s56, s56, 288
  s_and_b32 s57, s28, 1
  s_lshl_b32 s57, s57, 7
  s_add_u32 s56, s56, s57
  s_add_u32 s56, s56, 147456
  v_lshlrev_b32 v39, 3, v0
  v_add_u32 v39, s56, v39
  v_mov_b32 v60, 0xff800000
  s_cmp_lt_u32 s32, 2
  s_cbranch_scc1 L_qpre
  s_barrier
L_qpre:
  s_cmp_lg_u32 s28, 3
  s_cbranch_scc1 L_q2skip
  s_lshl_b32 s56, s31, 11
  s_lshl_b32 s57, s14, 8
  s_add_u32 s56, s56, s57
  s_add_u32 s56, s56, 278528
  s_add_u32 s100, s26, s56
  s_addc_u32 s101, s27, 0
  s_mov_b32 s33, 0
  s_branch L_q2poll1
L_q2poll:
  s_sleep 8
L_q2poll1:
  s_add_u32 s33, s33, 1
  s_cmp_gt_u32 s33, 200000
  s_cbranch_scc1 L_q2got
  s_load_dwordx16 s[36:51], s[100:101], 0 glc
  s_load_dwordx16 s[52:67], s[100:101], 64 glc
  s_load_dwordx16 s[68:83], s[100:101], 128 glc
  s_load_dwordx16 s[84:99], s[100:101], 192 glc
  s_waitcnt lgkmcnt(0)
  s_cmp_eq_u64 s[38:39], s[34:35]
  s_cbranch_scc0 L_q2poll
  s_cmp_eq_u64 s[42:43], s[34:35]
  s_cbranch_scc0 L_q2poll
  s_cmp_eq_u64 s[46:47], s[34:35]
  s_cbranch_scc0 L_q2poll
  s_cmp_eq_u64 s[50:51], s[34:35]
  s_cbranch_scc0 L_q2poll
  s_cmp_eq_u64 s[54:55], s[34:35]
  s_cbranch_scc0 L_q2poll
  s_cmp_eq_u64 s[58:59], s[34:35]
  s_cbranch_scc0 L_q2poll
  s_cmp_eq_u64 s[62:63], s[34:35]
  s_cbranch_scc0 L_q2poll
  s_cmp_eq_u64 s[66:67], s[34:35]
  s_cbranch_scc0 L_q2poll
  s_cmp_eq_u64 s[70:71], s[34:35]
  s_cbranch_scc0 L_q2poll
  s_cmp_eq_u64 s[74:75], s[34:35]
  s_cbranch_scc0 L_q2poll
  s_cmp_eq_u64 s[78:79], s[34:35]
  s_cbranch_scc0 L_q2poll
  s_cmp_eq_u64 s[82:83], s[34:35]
  s_cbranch_scc0 L_q2poll
  s_cmp_eq_u64 s[86:87], s[34:35]
  s_cbranch_scc0 L_q2poll
  s_cmp_eq_u64 s[90:91], s[34:35]
  s_cbranch_scc0 L_q2poll
  s_cmp_eq_u64 s[94:95], s[34:35]
  s_cbranch_scc0 L_q2poll
  s_cmp_eq_u64 s[98:99], s[34:35]
  s_cbranch_scc0 L_q2poll
L_q2got:
  v_writelane_b32 v50, s36, 0
  v_writelane_b32 v51, s37, 0
  v_writelane_b32 v50, s40, 1
  v_writelane_b32 v51, s41, 1
  v_writelane_b32 v50, s44, 2
  v_writelane_b32 v51, s45, 2
  v_writelane_b32 v50, s48, 3
  v_writelane_b32 v51, s49, 3
  v_writelane_b32 v50, s52, 4
  v_writelane_b32 v51, s53, 4
  v_writelane_b32 v50, s56, 5
  v_writelane_b32 v51, s57, 5
  v_writelane_b32 v50, s60, 6
  v_writelane_b32 v51, s61, 6
  v_writelane_b32 v50, s64, 7
  v_writelane_b32 v51, s65, 7
  v_writelane_b32 v50, s68, 8
  v_writelane_b32 v51, s69, 8
  v_writelane_b32 v50, s72, 9
  v_writelane_b32 v51, s73, 9
  v_writelane_b32 v50, s76, 10
  v_writelane_b32 v51, s77, 10
  v_writelane_b32 v50, s80, 11
  v_writelane_b32 v51, s81, 11
  v_writelane_b32 v50, s84, 12
  v_writelane_b32 v51, s85, 12
  v_writelane_b32 v50, s88, 13
  v_writelane_b32 v51, s89, 13
  v_writelane_b32 v50, s92, 14
  v_writelane_b32 v51, s93, 14
  v_writelane_b32 v50, s96, 15
  v_writelane_b32 v51, s97, 15
L_q2skip:
  s_cmp_lt_u32 s32, 2
  s_cbranch_scc1 L_qstart
L_spin7:
  ds_read_b32 v40, v9 offset:28
  s_waitcnt lgkmcnt(0)
  v_readfirstlane_b32 s56, v40
  s_nop 0
  s_cmp_ge_u32 s56, 4
  s_cbranch_scc0 L_spin7
L_qstart:
  s_mov_b32 s33, 0
  s_branch L_qpoll1
L_qpoll:
  s_sleep 8
L_qpoll1:
  s_add_u32 s33, s33, 1
  s_cmp_gt_u32 s33, 200000
  s_cbranch_scc1 L_qdone
  s_load_dwordx16 s[36:51], s[0:1], 0 glc
  s_load_dwordx16 s[52:67], s[0:1], 64 glc
  s_load_dwordx16 s[68:83], s[0:1], 128 glc
  s_load_dwordx16 s[84:99], s[0:1], 192 glc
  s_waitcnt lgkmcnt(0)
  s_cmp_eq_u64 s[38:39], s[34:35]
  s_cbranch_scc0 L_qpoll
  s_cmp_eq_u64 s[42:43], s[34:35]
  s_cbranch_scc0 L_qpoll
  s_cmp_eq_u64 s[46:47], s[34:35]
  s_cbranch_scc0 L_qpoll
  s_cmp_eq_u64 s[50:51], s[34:35]
  s_cbranch_scc0 L_qpoll
  s_cmp_eq_u64 s[54:55], s[34:35]
  s_cbranch_scc0 L_qpoll
  s_cmp_eq_u64 s[58:59], s[34:35]
  s_cbranch_scc0 L_qpoll
  s_cmp_eq_u64 s[62:63], s[34:35]
  s_cbranch_scc0 L_qpoll
  s_cmp_eq_u64 s[66:67], s[34:35]
  s_cbranch_scc0 L_qpoll
  s_cmp_eq_u64 s[70:71], s[34:35]
  s_cbranch_scc0 L_qpoll
  s_cmp_eq_u64 s[74:75], s[34:35]
  s_cbranch_scc0 L_qpoll
  s_cmp_eq_u64 s[78:79], s[34:35]
  s_cbranch_scc0 L_qpoll
  s_cmp_eq_u64 s[82:83], s[34:35]
  s_cbranch_scc0 L_qpoll
  s_cmp_eq_u64 s[86:87], s[34:35]
  s_cbranch_scc0 L_qpoll
  s_cmp_eq_u64 s[90:91], s[34:35]
  s_cbranch_scc0 L_qpoll
  s_cmp_eq_u64 s[94:95], s[34:35]
  s_cbranch_scc0 L_qpoll
  s_cmp_eq_u64 s[98:99], s[34:35]
  s_cbranch_scc0 L_qpoll
L_qdone:
  v_writelane_b32 v48, s36, 0
  v_writelane_b32 v49, s37, 0
  v_writelane_b32 v48, s40, 1
  v_writelane_b32 v49, s41, 1
  v_writelane_b32 v48, s44, 2
  v_writelane_b32 v49, s45, 2
  v_writelane_b32 v48, s48, 3
  v_writelane_b32 v49, s49, 3
  v_writelane_b32 v48, s52, 4
  v_writelane_b32 v49, s53, 4
  v_writelane_b32 v48, s56, 5
  v_writelane_b32 v49, s57, 5
  v_writelane_b32 v48, s60, 6
  v_writelane_b32 v49, s61, 6
  v_writelane_b32 v48, s64, 7
  v_writelane_b32 v49, s65, 7
  v_writelane_b32 v48, s68, 8
  v_writelane_b32 v49, s69, 8
  v_writelane_b32 v48, s72, 9
  v_writelane_b32 v49, s73, 9
  v_writelane_b32 v48, s76, 10
  v_writelane_b32 v49, s77, 10
  v_writelane_b32 v48, s80, 11
  v_writelane_b32 v49, s81, 11
  v_writelane_b32 v48, s84, 12
  v_writelane_b32 v49, s85, 12
  v_writelane_b32 v48, s88, 13
  v_writelane_b32 v49, s89, 13
  v_writelane_b32 v48, s92, 14
  v_writelane_b32 v49, s93, 14
  v_writelane_b32 v48, s96, 15
  v_writelane_b32 v49, s97, 15
  s_cmp_lg_u32 s28, 3
  s_cbranch_scc1 L_q2done
  v_lshlrev_b32 v42, 16, v48
  v_and_b32 v43, 0xffff0000, v48
  v_lshlrev_b32 v44, 16, v50
  v_and_b32 v45, 0xffff0000, v50
  v_pk_add_f32 v[42:43], v[42:43], v[44:45]
  v_cvt_pk_bf16_f32 v48, v42, v43
  v_lshlrev_b32 v42, 16, v49
  v_and_b32 v43, 0xffff0000, v49
  v_lshlrev_b32 v44, 16, v51
  v_and_b32 v45, 0xffff0000, v51
  v_pk_add_f32 v[42:43], v[42:43], v[44:45]
  v_cvt_pk_bf16_f32 v49, v42, v43
L_q2done:
  s_mov_b64 exec, 0xffff
  ds_write_b64 v39, v[48:49]
  s_mov_b64 exec, -1
  s_mov_b64 exec, 1
  ds_add_u32 v9, v8 offset:4
  s_mov_b64 exec, -1
  s_mov_b32 s96, s26
  s_mov_b32 s97, s27
  s_mov_b32 s98, 0x200000
  s_mov_b32 s99, 0x20000
  s_add_u32 s54, s28, 8
L_spin8:
  ds_read_b32 v40, v9 offset:0
  s_waitcnt lgkmcnt(0)
  v_readfirstlane_b32 s56, v40
  s_nop 0
  s_cmp_ge_u32 s56, 4
  s_cbranch_scc0 L_spin8
  s_mov_b32 s55, 0
  s_cmp_lt_u32 s54, s13
  s_cbranch_scc0 L_kr_b
  s_lshl_b32 s56, s54, 13
  v_add_u32 v54, s56, v30
  v_xor_b32 v55, 64, v54
  v_xor_b32 v56, 128, v54
  v_xor_b32 v57, 192, v54
  ds_read_b128 v[136:139], v54 offset:0
  ds_read_b128 v[140:143], v55 offset:0
  ds_read_b128 v[144:147], v56 offset:0
  ds_read_b128 v[148:151], v57 offset:0
  ds_read_b128 v[152:155], v54 offset:4096
  ds_read_b128 v[156:159], v55 offset:4096
  ds_read_b128 v[160:163], v56 offset:4096
  ds_read_b128 v[104:107], v57 offset:4096
  s_mov_b32 s55, 1
L_kr_b:
  s_mov_b32 s54, s28
  s_cmp_lt_u32 s54, s13
  s_cbranch_scc0 L_kr_a
  s_lshl_b32 s56, s54, 13
  v_add_u32 v54, s56, v30
  v_xor_b32 v55, 64, v54
  v_xor_b32 v56, 128, v54
  v_xor_b32 v57, 192, v54
  ds_read_b128 v[80:83], v54 offset:0
  ds_read_b128 v[84:87], v55 offset:0
  ds_read_b128 v[88:91], v56 offset:0
  ds_read_b128 v[92:95], v57 offset:0
  ds_read_b128 v[96:99], v54 offset:4096
  ds_read_b128 v[100:103], v55 offset:4096
  ds_read_b128 v[128:131], v56 offset:4096
  ds_read_b128 v[132:135], v57 offset:4096
  s_add_u32 s55, s55, 1
L_kr_a:
L_spin9:
  ds_read_b32 v40, v9 offset:4
  s_waitcnt lgkmcnt(0)
  v_readfirstlane_b32 s56, v40
  s_nop 0
  s_cmp_ge_u32 s56, 8
  s_cbranch_scc0 L_spin9
  s_cmp_eq_u32 s55, 0
  s_cbranch_scc1 L_qk_done
  ds_read_b128 v[64:67], v29 offset:0
  ds_read_b128 v[68:71], v29 offset:64
  ds_read_b128 v[72:75], v29 offset:128
  ds_read_b128 v[76:79], v29 offset:192
  s_waitcnt lgkmcnt(3)
  v_mfma_f32_16x16x32_bf16 v[120:123], v[80:83], v[64:67], 0
  v_mfma_f32_16x16x32_bf16 v[124:127], v[96:99], v[64:67], 0
  s_waitcnt lgkmcnt(2)
  v_mfma_f32_16x16x32_bf16 v[120:123], v[84:87], v[68:71], v[120:123]
  v_mfma_f32_16x16x32_bf16 v[124:127], v[100:103], v[68:71], v[124:127]
  s_waitcnt lgkmcnt(1)
  v_mfma_f32_16x16x32_bf16 v[120:123], v[88:91], v[72:75], v[120:123]
  v_mfma_f32_16x16x32_bf16 v[124:127], v[128:131], v[72:75], v[124:127]
  s_waitcnt lgkmcnt(0)
  v_mfma_f32_16x16x32_bf16 v[120:123], v[92:95], v[76:79], v[120:123]
  v_mfma_f32_16x16x32_bf16 v[124:127], v[132:135], v[76:79], v[124:127]
  s_cmp_eq_u32 s55, 2
  s_cbranch_scc0 L_qk_one
  v_mfma_f32_16x16x32_bf16 v[112:115], v[136:139], v[64:67], 0
  v_mfma_f32_16x16x32_bf16 v[116:119], v[152:155], v[64:67], 0
  v_mfma_f32_16x16x32_bf16 v[112:115], v[140:143], v[68:71], v[112:115]
  v_mfma_f32_16x16x32_bf16 v[116:119], v[156:159], v[68:71], v[116:119]
  v_mfma_f32_16x16x32_bf16 v[112:115], v[144:147], v[72:75], v[112:115]
  v_mfma_f32_16x16x32_bf16 v[116:119], v[160:163], v[72:75], v[116:119]
  v_mfma_f32_16x16x32_bf16 v[112:115], v[148:151], v[76:79], v[112:115]
  v_mfma_f32_16x16x32_bf16 v[116:119], v[104:107], v[76:79], v[116:119]
  s_nop 7
  v_max3_f32 v61, v112, v113, v114
  v_max3_f32 v62, v115, v116, v117
  v_max3_f32 v61, v61, v118, v119
  v_max_f32 v60, v61, v62
L_qk_one:
  s_nop 7
  v_max3_f32 v61, v120, v121, v122
  v_max3_f32 v62, v123, v124, v125
  v_max3_f32 v61, v61, v126, v127
  v_max3_f32 v60, v60, v61, v62
  v_mov_b32 v61, v60
  s_nop 1
  v_permlane16_swap_b32 v60, v61
  v_max_f32 v60, v60, v61
  v_mov_b32 v61, v60
  s_nop 1
  v_permlane32_swap_b32 v60, v61
  v_max_f32 v60, v60, v61
L_qk_done:
  s_mov_b64 exec, 0xf
  ds_write_b32 v31, v60
  s_mov_b64 exec, -1
  s_mov_b64 exec, 1
  ds_add_u32 v9, v8 offset:8
  s_mov_b64 exec, -1
L_spin10:
  ds_read_b32 v40, v9 offset:8
  s_waitcnt lgkmcnt(0)
  v_readfirstlane_b32 s56, v40
  s_nop 0
  s_cmp_ge_u32 s56, 8
  s_cbranch_scc0 L_spin10
  ds_read_b128 v[64:67], v32
  ds_read_b128 v[68:71], v32 offset:16
  v_mov_b32 v63, 0x3e0293ee
  v_mov_b32 v72, 0
  v_mov_b32 v73, 0
  s_waitcnt lgkmcnt(0)
  v_max3_f32 v61, v64, v65, v66
  v_max3_f32 v62, v67, v68, v69
  v_max3_f32 v61, v61, v70, v71
  v_max_f32 v61, v61, v62
  v_mul_f32 v20, v61, v63
  v_sub_f32 v62, 0, v20
  s_cmp_eq_u32 s55, 0
  s_cbranch_scc1 L_ex_none
  v_fma_f32 v120, v120, v63, v62
  v_fma_f32 v121, v121, v63, v62
  v_fma_f32 v122, v122, v63, v62
  v_fma_f32 v123, v123, v63, v62
  v_fma_f32 v124, v124, v63, v62
  v_fma_f32 v125, v125, v63, v62
  v_fma_f32 v126, v126, v63, v62
  v_fma_f32 v127, v127, v63, v62
  v_exp_f32 v120, v120
  v_exp_f32 v121, v121
  v_exp_f32 v122, v122
  v_exp_f32 v123, v123
  v_exp_f32 v124, v124
  v_exp_f32 v125, v125
  v_exp_f32 v126, v126
  v_exp_f32 v127, v127
  v_cvt_pk_bf16_f32 v76, v120, v121
  v_cvt_pk_bf16_f32 v77, v122, v123
  v_cvt_pk_bf16_f32 v78, v124, v125
  v_cvt_pk_bf16_f32 v79, v126, v127
  v_pk_add_f32 v[120:121], v[120:121], v[122:123]
  v_pk_add_f32 v[124:125], v[124:125], v[126:127]
  v_pk_add_f32 v[72:73], v[72:73], v[120:121]
  v_pk_add_f32 v[72:73], v[72:73], v[124:125]
  s_mov_b32 exec_lo, 0x000f000f
  s_mov_b32 exec_hi, 0x000f000f
  ds_write_b128 v33, v[76:79]
  s_mov_b64 exec, -1
  s_cmp_eq_u32 s55, 2
  s_cbranch_scc0 L_ex_sum
  v_fma_f32 v112, v112, v63, v62
  v_fma_f32 v113, v113, v63, v62
  v_fma_f32 v114, v114, v63, v62
  v_fma_f32 v115, v115, v63, v62
  v_fma_f32 v116, v116, v63, v62
  v_fma_f32 v117, v117, v63, v62
  v_fma_f32 v118, v118, v63, v62
  v_fma_f32 v119, v119, v63, v62
  v_exp_f32 v112, v112
  v_exp_f32 v113, v113
  v_exp_f32 v114, v114
  v_exp_f32 v115, v115
  v_exp_f32 v116, v116
  v_exp_f32 v117, v117
  v_exp_f32 v118, v118
  v_exp_f32 v119, v119
  v_cvt_pk_bf16_f32 v80, v112, v113
  v_cvt_pk_bf16_f32 v81, v114, v115
  v_cvt_pk_bf16_f32 v82, v116, v117
  v_cvt_pk_bf16_f32 v83, v118, v119
  v_pk_add_f32 v[112:113], v[112:113], v[114:115]
  v_pk_add_f32 v[116:117], v[116:117], v[118:119]
  v_pk_add_f32 v[72:73], v[72:73], v[112:113]
  v_pk_add_f32 v[72:73], v[72:73], v[116:117]
  s_mov_b32 exec_lo, 0x000f000f
  s_mov_b32 exec_hi, 0x000f000f
  ds_write_b128 v33, v[80:83] offset:2048
  s_mov_b64 exec, -1
L_ex_sum:
  v_add_f32 v72, v72, v73
  v_mov_b32 v73, v72
  s_nop 1
  v_permlane16_swap_b32 v72, v73
  v_add_f32 v72, v72, v73
  v_mov_b32 v73, v72
  s_nop 1
  v_permlane32_swap_b32 v72, v73
  v_add_f32 v72, v72, v73
L_ex_none:
  s_mov_b64 exec, 0xf
  ds_write_b32 v31, v72 offset:128
  s_mov_b64 exec, -1
  s_mov_b64 exec, 1
  ds_add_u32 v9, v8 offset:12
  s_mov_b64 exec, -1
L_spin11:
  ds_read_b32 v40, v9 offset:12
  s_waitcnt lgkmcnt(0)
  v_readfirstlane_b32 s56, v40
  s_nop 0
  s_cmp_ge_u32 s56, 8
  s_cbranch_scc0 L_spin11
  ds_read_b128 v[64:67], v35
  ds_read_b128 v[68:71], v35 offset:16
  ds_read_b128 v[104:107], v34 offset:0
  ds_read_b128 v[108:111], v34 offset:256
  ds_read_b128 v[112:115], v34 offset:512
  ds_read_b128 v[116:119], v34 offset:768
  ds_read_b128 v[120:123], v34 offset:1024
  ds_read_b128 v[124:127], v34 offset:1280
  ds_read_b128 v[128:131], v34 offset:1536
  ds_read_b128 v[132:135], v34 offset:1792
  ds_read_b128 v[136:139], v34 offset:2048
  ds_read_b128 v[140:143], v34 offset:2304
  v_mov_b32 v22, s34
  v_mov_b32 v23, s35
  s_and_b32 s57, s28, 3
  s_lshl_b64 s[58:59], 1, s57
  s_waitcnt lgkmcnt(10)
  v_pk_add_f32 v[64:65], v[64:65], v[66:67]
  v_pk_add_f32 v[68:69], v[68:69], v[70:71]
  v_pk_add_f32 v[64:65], v[64:65], v[68:69]
  v_add_f32 v21, v64, v65
  s_cmp_ge_u32 s28, 4
  s_cbranch_scc1 L_nost
  s_mov_b64 exec, s[58:59]
  buffer_store_dwordx4 v[20:23], v3, s[96:99], s9 offen sc1
  s_mov_b64 exec, -1
L_nost:
  s_cmp_lt_u32 s3, 14
  s_cbranch_scc0 L_nohg
  buffer_load_dwordx4 v[4:7], v36, s[96:99], s12 offen sc1
L_nohg:
  s_waitcnt lgkmcnt(0)
  s_barrier
  s_cmp_ge_u32 s32, 2
  s_cbranch_scc1 L_pvl
  ds_read_b64_tr_b16 v[144:145], v17 offset:0
  ds_read_b64_tr_b16 v[146:147], v17 offset:4096
  ds_read_b64_tr_b16 v[148:149], v17 offset:8192
  ds_read_b64_tr_b16 v[150:151], v17 offset:12288
  ds_read_b64_tr_b16 v[152:153], v17 offset:16384
  ds_read_b64_tr_b16 v[154:155], v17 offset:20480
  ds_read_b64_tr_b16 v[156:157], v17 offset:24576
  ds_read_b64_tr_b16 v[158:159], v17 offset:28672
  s_waitcnt lgkmcnt(6)
  v_mfma_f32_16x16x32_bf16 v[96:99], v[144:147], v[104:107], 0
  s_waitcnt lgkmcnt(4)
  v_mfma_f32_16x16x32_bf16 v[96:99], v[148:151], v[108:111], v[96:99]
  s_waitcnt lgkmcnt(2)
  v_mfma_f32_16x16x32_bf16 v[96:99], v[152:155], v[112:115], v[96:99]
  s_waitcnt lgkmcnt(0)
  v_mfma_f32_16x16x32_bf16 v[96:99], v[156:159], v[116:119], v[96:99]
  s_barrier
  ds_read_b64_tr_b16 v[144:145], v17 offset:32768
  ds_read_b64_tr_b16 v[146:147], v17 offset:36864
  ds_read_b64_tr_b16 v[148:149], v17 offset:40960
  ds_read_b64_tr_b16 v[150:151], v17 offset:45056
  s_waitcnt lgkmcnt(2)
  v_mfma_f32_16x16x32_bf16 v[96:99], v[144:147], v[120:123], v[96:99]
  s_waitcnt lgkmcnt(0)
  v_mfma_f32_16x16x32_bf16 v[96:99], v[148:151], v[124:127], v[96:99]
  s_branch L_pvdone
L_pvl:
  ds_read_b64_tr_b16 v[144:145], v18 offset:0
  ds_read_b64_tr_b16 v[146:147], v18 offset:4096
  ds_read_b64_tr_b16 v[148:149], v18 offset:8192
  ds_read_b64_tr_b16 v[150:151], v18 offset:12288
  s_waitcnt lgkmcnt(2)
  v_mfma_f32_16x16x32_bf16 v[96:99], v[144:147], v[136:139], 0
  s_waitcnt lgkmcnt(0)
  v_mfma_f32_16x16x32_bf16 v[96:99], v[148:151], v[140:143], v[96:99]
  ds_read_b64_tr_b16 v[144:145], v17 offset:0
  ds_read_b64_tr_b16 v[146:147], v17 offset:4096
  ds_read_b64_tr_b16 v[148:149], v17 offset:8192
  ds_read_b64_tr_b16 v[150:151], v17 offset:12288
  ds_read_b64_tr_b16 v[152:153], v17 offset:16384
  ds_read_b64_tr_b16 v[154:155], v17 offset:20480
  s_waitcnt lgkmcnt(4)
  v_mfma_f32_16x16x32_bf16 v[96:99], v[144:147], v[104:107], v[96:99]
  s_waitcnt lgkmcnt(2)
  v_mfma_f32_16x16x32_bf16 v[96:99], v[148:151], v[108:111], v[96:99]
  s_waitcnt lgkmcnt(0)
  v_mfma_f32_16x16x32_bf16 v[96:99], v[152:155], v[112:115], v[96:99]
  ds_read_b64_tr_b16 v[144:145], v17 offset:24576
  ds_read_b64_tr_b16 v[146:147], v17 offset:28672
  ds_read_b64_tr_b16 v[148:149], v17 offset:32768
  ds_read_b64_tr_b16 v[150:151], v17 offset:36864
  ds_read_b64_tr_b16 v[152:153], v17 offset:40960
  ds_read_b64_tr_b16 v[154:155], v17 offset:45056
  s_waitcnt lgkmcnt(4)
  v_mfma_f32_16x16x32_bf16 v[96:99], v[144:147], v[116:119], v[96:99]
  s_waitcnt lgkmcnt(2)
  v_mfma_f32_16x16x32_bf16 v[96:99], v[148:151], v[120:123], v[96:99]
  s_waitcnt lgkmcnt(0)
  v_mfma_f32_16x16x32_bf16 v[96:99], v[152:155], v[124:127], v[96:99]
  s_barrier
  ds_read_b64_tr_b16 v[144:145], v17 offset:49152
  ds_read_b64_tr_b16 v[146:147], v17 offset:53248
  ds_read_b64_tr_b16 v[148:149], v17 offset:57344
  ds_read_b64_tr_b16 v[150:151], v17 offset:61440
  s_waitcnt lgkmcnt(2)
  v_mfma_f32_16x16x32_bf16 v[96:99], v[144:147], v[128:131], v[96:99]
  s_waitcnt lgkmcnt(0)
  v_mfma_f32_16x16x32_bf16 v[96:99], v[148:151], v[132:135], v[96:99]
L_pvdone:
  s_nop 7
  v_and_or_b32 v96, v96, v15, s16
  v_and_or_b32 v97, v97, v15, s17
  v_and_or_b32 v98, v98, v15, s18
  v_and_or_b32 v99, v99, v15, s19
  s_mov_b32 exec_lo, 0x000f000f
  s_mov_b32 exec_hi, 0x000f000f
  buffer_store_dwordx4 v[96:99], v16, s[96:99], s6 offen sc1
  s_mov_b64 exec, -1
  s_cmp_lt_u32 s3, 14
  s_cbranch_scc0 L_noh2
  s_waitcnt vmcnt(1)
  s_mov_b32 s33, 0
L_hchk:
  v_cmp_ne_u32 vcc, s34, v6
  v_cmp_ne_u32 s[56:57], s35, v7
  s_nop 0
  s_or_b64 vcc, vcc, s[56:57]
  s_nop 1
  s_cbranch_vccz L_hok
  s_add_u32 s33, s33, 1
  s_cmp_gt_u32 s33, 200000
  s_cbranch_scc1 L_hok
  buffer_load_dwordx4 v[4:7], v36, s[96:99], s12 offen sc1
  s_waitcnt vmcnt(0)
  s_branch L_hchk
L_hok:
  v_mov_b32 v40, v4
  v_mov_b32 v41, v5
  s_nop 0
  v_permlane32_swap_b32 v40, v4
  v_permlane32_swap_b32 v41, v5
  v_lshlrev_b32 v42, 16, v40
  v_and_b32 v43, 0xffff0000, v40
  v_lshlrev_b32 v44, 16, v41
  v_and_b32 v45, 0xffff0000, v41
  v_lshlrev_b32 v46, 16, v4
  v_and_b32 v47, 0xffff0000, v4
  v_lshlrev_b32 v48, 16, v5
  v_and_b32 v49, 0xffff0000, v5
  v_pk_mul_f32 v[42:43], v[42:43], v[46:47]
  v_pk_mul_f32 v[44:45], v[44:45], v[48:49]
  v_cvt_pk_bf16_f32 v4, v42, v43
  v_cvt_pk_bf16_f32 v5, v44, v45
  s_mov_b64 exec, 0xffffffff
  ds_write_b64 v37, v[4:5]
  s_mov_b64 exec, -1
L_noh2:
  s_waitcnt lgkmcnt(0)
  s_barrier
  ds_read_b64_tr_b16 v[120:121], v18 offset:16384
  ds_read_b64_tr_b16 v[122:123], v18 offset:20480
  ds_read_b64_tr_b16 v[124:125], v18 offset:24576
  ds_read_b64_tr_b16 v[126:127], v18 offset:28672
  s_cmp_lt_u32 s3, 14
  s_cbranch_scc0 L_nodown
  s_cmp_ge_u32 s28, 4
  s_cbranch_scc1 L_nodown
  v_bfe_u32 v64, v0, 2, 2
  v_lshl_add_u32 v65, v2, 2, v64
  v_bfe_u32 v66, v65, 1, 2
  v_lshlrev_b32 v66, 1, v66
  v_bfe_u32 v67, v0, 1, 1
  s_lshl_b32 s57, s28, 1
  v_add_u32 v67, s57, v67
  v_xor_b32 v66, v66, v67
  v_lshlrev_b32 v66, 4, v66
  v_lshl_add_u32 v66, v65, 7, v66
  v_and_b32 v67, 1, v0
  v_lshl_add_u32 v66, v67, 3, v66
  v_mul_u32_u24 v67, 288, v26
  v_lshl_add_u32 v67, v2, 4, v67
  v_add_u32 v67, 152832, v67
  ds_read_b64_tr_b16 v[144:145], v66 offset:32768
  ds_read_b64_tr_b16 v[146:147], v66 offset:34816
  ds_read_b128 v[128:131], v67 offset:0
  ds_read_b64_tr_b16 v[148:149], v66 offset:36864
  ds_read_b64_tr_b16 v[150:151], v66 offset:38912
  ds_read_b128 v[132:135], v67 offset:64
  ds_read_b64_tr_b16 v[152:153], v66 offset:40960
  ds_read_b64_tr_b16 v[154:155], v66 offset:43008
  ds_read_b128 v[136:139], v67 offset:128
  ds_read_b64_tr_b16 v[156:157], v66 offset:45056
  ds_read_b64_tr_b16 v[158:159], v66 offset:47104
  ds_read_b128 v[140:143], v67 offset:192
  s_waitcnt lgkmcnt(9)
  v_mfma_f32_16x16x32_bf16 v[116:119], v[144:147], v[128:131], 0
  s_waitcnt lgkmcnt(6)
  v_mfma_f32_16x16x32_bf16 v[116:119], v[148:151], v[132:135], v[116:119]
  s_waitcnt lgkmcnt(3)
  v_mfma_f32_16x16x32_bf16 v[116:119], v[152:155], v[136:139], v[116:119]
  s_waitcnt lgkmcnt(0)
  v_mfma_f32_16x16x32_bf16 v[116:119], v[156:159], v[140:143], v[116:119]
  s_mov_b32 exec_lo, 0x00ff00ff
  s_mov_b32 exec_hi, 0x00ff00ff
  s_nop 5
  v_and_or_b32 v116, v116, v15, s16
  v_and_or_b32 v117, v117, v15, s17
  v_and_or_b32 v118, v118, v15, s18
  v_and_or_b32 v119, v119, v15, s19
  buffer_store_dwordx4 v[116:119], v38, s[96:99], s11 offen sc1
  s_mov_b64 exec, -1
L_nodown:
  s_mov_b32 s33, 0
  s_branch L_apoll1
L_apoll:
  s_sleep 2
L_apoll1:
  buffer_load_dwordx4 v[84:87], v24, s[96:99], s8 offen sc1
  buffer_load_dwordx4 v[88:91], v19, s[96:99], s7 offen sc1
  s_add_u32 s33, s33, 1
  s_cmp_gt_u32 s33, 200000
  s_cbranch_scc1 L_aok
  s_waitcnt vmcnt(0)
  v_xor_b32 v52, s16, v88
  v_xor_b32 v53, s17, v89
  v_xor_b32 v54, s18, v90
  v_xor_b32 v55, s19, v91
  v_or3_b32 v52, v52, v53, v54
  v_or_b32 v56, v52, v55
  v_and_b32 v56, 0xfff, v56
  v_xor_b32 v57, s34, v86
  v_xor_b32 v58, s35, v87
  v_or3_b32 v56, v56, v57, v58
  v_cmp_ne_u32 vcc, 0, v56
  s_nop 4
  s_cbranch_vccnz L_apoll
L_aok:
  s_waitcnt vmcnt(0)
  v_max_f32_dpp v86, v84, v84 quad_perm:[1,0,3,2] row_mask:0xf bank_mask:0xf
  v_and_b32 v88, v15, v88
  v_and_b32 v89, v15, v89
  v_and_b32 v90, v15, v90
  v_and_b32 v91, v15, v91
  v_max_f32_dpp v86, v86, v86 quad_perm:[2,3,0,1] row_mask:0xf bank_mask:0xf
  v_sub_f32 v86, v84, v86
  v_exp_f32 v86, v86
  s_nop 0
  v_mul_f32 v87, v86, v85
  s_nop 1
  v_add_f32_dpp v87, v87, v87 quad_perm:[1,0,3,2] row_mask:0xf bank_mask:0xf
  s_nop 1
  v_add_f32_dpp v87, v87, v87 quad_perm:[2,3,0,1] row_mask:0xf bank_mask:0xf
  v_rcp_f32 v87, v87
  s_nop 0
  v_mul_f32 v86, v86, v87
  v_mul_f32 v88, v88, v86
  v_mul_f32 v89, v89, v86
  v_mul_f32 v90, v90, v86
  v_mul_f32 v91, v91, v86
  v_add_f32_dpp v88, v88, v88 quad_perm:[1,0,3,2] row_mask:0xf bank_mask:0xf
  v_add_f32_dpp v89, v89, v89 quad_perm:[1,0,3,2] row_mask:0xf bank_mask:0xf
  v_add_f32_dpp v90, v90, v90 quad_perm:[1,0,3,2] row_mask:0xf bank_mask:0xf
  v_add_f32_dpp v91, v91, v91 quad_perm:[1,0,3,2] row_mask:0xf bank_mask:0xf
  v_add_f32_dpp v88, v88, v88 quad_perm:[2,3,0,1] row_mask:0xf bank_mask:0xf
  v_add_f32_dpp v89, v89, v89 quad_perm:[2,3,0,1] row_mask:0xf bank_mask:0xf
  v_add_f32_dpp v90, v90, v90 quad_perm:[2,3,0,1] row_mask:0xf bank_mask:0xf
  v_add_f32_dpp v91, v91, v91 quad_perm:[2,3,0,1] row_mask:0xf bank_mask:0xf
  v_cvt_pk_bf16_f32 v88, v88, v89
  v_cvt_pk_bf16_f32 v89, v90, v91
  s_mov_b32 exec_lo, 0x11111111
  s_mov_b32 exec_hi, 0x11111111
  ds_write_b64 v25, v[88:89]
  s_mov_b64 exec, -1
  s_waitcnt lgkmcnt(0)
  s_barrier
  ds_read_b128 v[100:103], v27 offset:0
  ds_read_b128 v[104:107], v27 offset:64
  s_waitcnt lgkmcnt(1)
  v_mfma_f32_16x16x32_bf16 v[108:111], v[120:123], v[100:103], 0
  s_waitcnt lgkmcnt(0)
  v_mfma_f32_16x16x32_bf16 v[108:111], v[124:127], v[104:107], v[108:111]
  s_mov_b32 exec_lo, 0x00ff00ff
  s_mov_b32 exec_hi, 0x00ff00ff
  s_nop 5
  v_and_or_b32 v108, v108, v15, s16
  v_and_or_b32 v109, v109, v15, s17
  v_and_or_b32 v110, v110, v15, s18
  v_and_or_b32 v111, v111, v15, s19
  buffer_store_dwordx4 v[108:111], v28, s[96:99], s10 offen sc1
  s_mov_b64 exec, -1
  s_cmp_lt_u32 s28, 3
  s_cbranch_scc1 L_fin_end
  s_add_u32 s56, s29, 5
  s_and_b32 s56, s56, 7
  s_lshl_b32 s56, s56, 2
  s_add_u32 s55, s56, s32
  v_and_b32 v64, 3, v0
  v_lshrrev_b32 v65, 2, v0
  s_lshl_b32 s57, s55, 6
  s_lshl_b32 s58, s31, 11
  s_add_u32 s57, s57, s58
  s_sub_u32 s59, s28, 4
  s_lshl_b32 s59, s59, 18
  s_add_u32 s58, s57, s59
  s_add_u32 s58, s58, 1048576
  s_add_u32 s59, s57, 294912
  s_cmp_eq_u32 s28, 3
  s_cselect_b32 s58, s59, s58
  s_cselect_b32 s60, 0x00ffffff, -1
  v_lshlrev_b32 v66, 14, v65
  v_lshl_add_u32 v66, v64, 4, v66
  v_mov_b32 v84, s16
  v_mov_b32 v85, s17
  v_mov_b32 v86, s18
  v_mov_b32 v87, s19
  v_and_b32 v67, 1, v2
  v_lshlrev_b32 v67, 1, v67
  v_lshrrev_b32 v68, 1, v2
  v_or_b32 v67, v67, v68
  v_lshl_add_u32 v67, v64, 2, v67
  v_lshlrev_b32 v67, 2, v67
  s_sub_u32 s57, s28, 3
  s_lshl_b32 s57, s57, 6
  s_add_u32 s57, s57, 155200
  v_add_u32 v67, s57, v67
  s_lshl_b32 s61, s31, 9
  s_lshl_b32 s62, s55, 4
  s_add_u32 s61, s61, s62
  v_add_u32 v70, s61, v1
  v_lshlrev_b32 v70, 1, v70
  s_cmp_lg_u32 s28, 7
  s_cbranch_scc1 L_fx
  global_load_ushort v69, v70, s[4:5]
L_fx:
  s_mov_b32 s33, 0
  s_sleep 16
  s_branch L_bpoll1
L_bpoll:
  s_sleep 2
L_bpoll1:
  s_mov_b32 exec_hi, s60
  buffer_load_dwordx4 v[84:87], v66, s[96:99], s58 offen sc1
  s_mov_b32 exec_hi, -1
  s_add_u32 s33, s33, 1
  s_cmp_gt_u32 s33, 200000
  s_cbranch_scc1 L_bok
  s_waitcnt vmcnt(0)
  v_xor_b32 v52, s16, v84
  v_xor_b32 v53, s17, v85
  v_xor_b32 v54, s18, v86
  v_xor_b32 v55, s19, v87
  v_or3_b32 v52, v52, v53, v54
  v_or_b32 v56, v52, v55
  v_and_b32 v56, 0xfff, v56
  v_cmp_ne_u32 vcc, 0, v56
  s_nop 4
  s_cbranch_vccnz L_bpoll
L_bok:
  s_waitcnt vmcnt(0)
  v_and_b32 v84, v15, v84
  v_and_b32 v85, v15, v85
  v_and_b32 v86, v15, v86
  v_and_b32 v87, v15, v87
  v_add_f32_dpp v84, v84, v84 row_ror:4 row_mask:0xf bank_mask:0xf
  v_add_f32_dpp v85, v85, v85 row_ror:4 row_mask:0xf bank_mask:0xf
  v_add_f32_dpp v86, v86, v86 row_ror:4 row_mask:0xf bank_mask:0xf
  v_add_f32_dpp v87, v87, v87 row_ror:4 row_mask:0xf bank_mask:0xf
  v_add_f32_dpp v84, v84, v84 row_ror:8 row_mask:0xf bank_mask:0xf
  v_add_f32_dpp v85, v85, v85 row_ror:8 row_mask:0xf bank_mask:0xf
  v_add_f32_dpp v86, v86, v86 row_ror:8 row_mask:0xf bank_mask:0xf
  v_add_f32_dpp v87, v87, v87 row_ror:8 row_mask:0xf bank_mask:0xf
  v_permlane32_swap_b32 v84, v85
  s_nop 0
  v_permlane32_swap_b32 v86, v87
  v_add_f32 v84, v84, v85
  v_add_f32 v86, v86, v87
  s_nop 1
  v_permlane16_swap_b32 v84, v86
  v_add_f32 v84, v84, v86
  s_mov_b32 exec_lo, 0x000f000f
  s_mov_b32 exec_hi, 0x000f000f
  ds_write_b32 v67, v84
  s_mov_b64 exec, -1
  s_mov_b64 exec, 1
  ds_add_u32 v9, v8 offset:32
  s_mov_b64 exec, -1
  s_cmp_lg_u32 s28, 7
  s_cbranch_scc1 L_fin_end
  v_lshlrev_b32 v71, 2, v1
  v_add_u32 v71, 155200, v71
L_spin12:
  ds_read_b32 v40, v9 offset:32
  s_waitcnt lgkmcnt(0)
  v_readfirstlane_b32 s56, v40
  s_nop 0
  s_cmp_ge_u32 s56, 5
  s_cbranch_scc0 L_spin12
  ds_read_b32 v100, v71
  ds_read_b32 v84, v71 offset:64
  ds_read_b32 v85, v71 offset:128
  ds_read_b32 v86, v71 offset:192
  ds_read_b32 v87, v71 offset:256
  s_waitcnt lgkmcnt(4)
  v_cvt_pk_bf16_f32 v100, v100, v100
  v_lshlrev_b32 v100, 16, v100
  v_mul_f32 v101, 0xbfb8aa3b, v100
  v_exp_f32 v101, v101
  s_nop 0
  v_add_f32 v101, 1.0, v101
  v_rcp_f32 v101, v101
  s_nop 0
  v_mul_f32 v101, v100, v101
  v_cvt_pk_bf16_f32 v101, v101, v101
  v_lshlrev_b32 v101, 16, v101
  s_waitcnt lgkmcnt(0)
  v_add_f32 v84, v84, v85
  v_add_f32 v86, v86, v87
  v_add_f32 v84, v84, v86
  v_cvt_pk_bf16_f32 v84, v84, v84
  v_lshlrev_b32 v84, 16, v84
  v_mul_f32 v84, v84, v101
  v_cvt_pk_bf16_f32 v84, v84, v84
  v_lshlrev_b32 v84, 16, v84
  v_lshlrev_b32 v69, 16, v69
  v_add_f32 v84, v69, v84
  v_cvt_pk_bf16_f32 v84, v84, v84
  s_mov_b64 exec, 0xffff
  global_store_short v70, v84, s[22:23]
  s_mov_b64 exec, -1
  s_cmp_lg_u32 s2, 0
  s_cbranch_scc1 L_fin_end
  v_mov_b32 v72, s34
  v_mov_b32 v73, s35
  v_mov_b32 v74, 0
  s_mov_b64 exec, 1
  buffer_store_dwordx2 v[72:73], v74, s[96:99], 0 offen sc1
  s_mov_b64 exec, -1
L_fin_end:
  s_branch L_stout
L_stout:
L_end:
  s_endpgm
L_code_end:
.fill 256, 4, 0xbf800000

.set L_code_bytes, L_code_end - recurrent_scan__sliding_block_cached__geglu_ffn__decode_kernel
.section .rodata,"a"
.p2align 6
.amdhsa_kernel recurrent_scan__sliding_block_cached__geglu_ffn__decode_kernel
  .amdhsa_next_free_vgpr 168
  .amdhsa_next_free_sgpr 102
  .amdhsa_accum_offset 168
  .amdhsa_group_segment_fixed_size 0
  .amdhsa_kernarg_size 96
  .amdhsa_user_sgpr_count 2
  .amdhsa_user_sgpr_kernarg_segment_ptr 1
  .amdhsa_system_sgpr_workgroup_id_x 1
  .amdhsa_float_denorm_mode_32 3
.end_amdhsa_kernel
```
